```python
import torch

def _softmax(x, axis=-1):
    return torch.softmax(x, dim=axis)
def _gelu(x):
    return torch.nn.functional.gelu(x, approximate="tanh")
def _silu(x):
    return torch.nn.functional.silu(x)
def _sigmoid(x):
    return torch.sigmoid(x)
def _layernorm(x, axis=-1, eps=1e-5):
    m = x.mean(dim=axis, keepdim=True)
    v = x.var(dim=axis, keepdim=True, unbiased=False)
    return (x - m) / torch.sqrt(v + eps)
def _scatter_add(tgt, idx, src, axis=0):
    return tgt.clone().index_add_(axis, idx, src)
def _segment_sum(src, seg, n):
    out = torch.zeros((n,) + src.shape[1:], dtype=src.dtype)
    return out.index_add_(0, seg, src)
def _pad(x, pw):
    flat = tuple(v for pair in reversed(pw) for v in pair)
    return torch.nn.functional.pad(x, flat)

kernel_name = 'standalone__moe_arch_mod__prompt'

def setup_inputs():

    _w = (lambda a: (lambda t: t.to(torch.bfloat16) if t.is_floating_point() else t)(torch.as_tensor(a)))
    B, S, D, F, C = 1, 2048, 576, 4608, 8
    return {
        "x": _w((lambda *s: torch.randn(*s, dtype=torch.bfloat16) * 0.1)(B, S, D)),
        "w_r": _w((lambda *s: torch.randn(*s, dtype=torch.bfloat16) * 0.1)(D)),
        "w_gate": _w((lambda *s: torch.randn(*s, dtype=torch.bfloat16) * 0.1)(D, F)),
        "w_up": _w((lambda *s: torch.randn(*s, dtype=torch.bfloat16) * 0.1)(D, F)),
        "w_down": _w((lambda *s: torch.randn(*s, dtype=torch.bfloat16) * 0.1)(F, D)),
    }

def reference(x, w_r, w_gate, w_up, w_down):
    B, S, D = x.shape
    C = 8
    r = x @ w_r
    idx = torch.argsort(-r, axis=-1)[:, :C]
    idx_e = (lambda x, n, axis: torch.repeat_interleave(x, n, dim=axis))(idx.reshape(B, C, 1), D, axis=2)
    x_sel = (lambda x, i, axis: torch.take_along_dim(x, i, dim=axis))(x, idx_e, axis=1)
    g = _silu(x_sel @ w_gate)
    u = x_sel @ w_up
    y = (g * u) @ w_down
    r_sel = _sigmoid((lambda x, i, axis: torch.take_along_dim(x, i, dim=axis))(r, idx, axis=1))
    y = y * r_sel.reshape(B, C, 1)
    b_off = (torch.arange(B) * S).reshape(B, 1)
    flat_idx = (idx + b_off).reshape(B * C)
    zero = (x * 0.0).reshape(B * S, D)
    upd = _scatter_add(zero, flat_idx, y.reshape(B * C, D), axis=0)
    return x + upd.reshape(B, S, D)
```

```asm
; @launch grid=(256,1,1) block=(384,1,1) lds=119936
.amdgcn_target "amdgcn-amd-amdhsa--gfx950"
.text
.p2align 12
.fill 0x340, 4, 0xbf800000
.globl standalone__moe_arch_mod__prompt_kernel
.p2align 8
.type standalone__moe_arch_mod__prompt_kernel,@function
standalone__moe_arch_mod__prompt_kernel:
    s_cmp_ge_u32 s2, 256
    s_cbranch_scc1 END0
    s_load_dwordx16 s[4:19], s[0:1], 0
    s_getpc_b64 s[22:23]
CPC:
    v_lshlrev_b32 v1, 7, v0
    v_min_u32 v1, CODE_END-CPC-4, v1
    global_load_dword v244, v1, s[22:23]
    v_lshrrev_b32 v1, 6, v0
    v_and_b32 v0, 63, v0
    v_readfirstlane_b32 s3, v1
    v_lshrrev_b32 v1, 3, v0
    v_and_b32 v2, 7, v0
    v_lshlrev_b32 v2, 4, v2
    s_sub_u32 s3, s3, 1
    s_cbranch_scc1 ROUTER
    s_barrier
    s_cmp_lt_u32 s2, 112
    s_cbranch_scc1 HELPER
    s_cmp_eq_u32 s3, 4
    s_cbranch_scc1 SEL
    s_branch FFN
ROUTER:
    s_setprio 2
    v_mul_u32_u24 v3, 1152, v1
    s_mul_i32 s50, s2, 9216
    v_add3_u32 v3, v3, v2, s50
    s_lshl_b32 s52, s2, 12
    s_add_u32 s52, s52, 1048576
    s_cmp_lt_u32 s2, 112
    s_cselect_b32 s52, 117440512, s52
    v_mov_b32 v4, -1
    v_mov_b32 v5, -1
    v_mov_b32 v6, -1
    v_mov_b32 v7, -1
    s_getreg_b32 s44, hwreg(HW_REG_XCC_ID)
    v_cmp_gt_u32 vcc, 32, v0
    v_mov_b32 v96, s44
    v_mov_b32 v97, -1
    v_mov_b32 v98, -1
    v_mov_b32 v99, -1
    v_cndmask_b32 v96, v96, v4, vcc
    v_lshlrev_b32 v80, 4, v0
    s_mov_b32 m0, 110592
    v_add_u32 v95, 110592, v2
    s_waitcnt lgkmcnt(0)
    s_load_dwordx2 s[20:21], s[18:19], 0
    global_load_lds_dwordx4 v80, s[6:7]
    s_mov_b64 exec, 0xff
    global_load_lds_dwordx4 v80, s[6:7] offset:1024
    s_mov_b64 exec, -1
    global_load_dwordx4 v[8:11], v3, s[4:5] offset:0
    global_load_dwordx4 v[12:15], v3, s[4:5] offset:128
    global_load_dwordx4 v[16:19], v3, s[4:5] offset:256
    global_load_dwordx4 v[20:23], v3, s[4:5] offset:384
    global_load_dwordx4 v[24:27], v3, s[4:5] offset:512
    global_load_dwordx4 v[28:31], v3, s[4:5] offset:640
    global_load_dwordx4 v[32:35], v3, s[4:5] offset:768
    global_load_dwordx4 v[36:39], v3, s[4:5] offset:896
    global_load_dwordx4 v[40:43], v3, s[4:5] offset:1024
    s_mov_b32 s28, s18
    s_and_b32 s29, s19, 0xffff
    s_mov_b32 s30, 4194304
    s_mov_b32 s31, 0x20000
    buffer_store_dwordx4 v[96:99], v80, s[28:31], s52 offen sc1
    buffer_store_dwordx4 v[4:7], v80, s[28:31], s52 offen offset:1024 sc1
    buffer_store_dwordx4 v[4:7], v80, s[28:31], s52 offen offset:2048 sc1
    s_barrier
    v_lshl_add_u32 v85, s2, 3, v1
    v_and_b32 v86, 3, v1
    v_mul_u32_u24 v87, 5, v86
    v_cmp_ne_u32 vcc, 0, v86
    v_sub_u32 v88, 2047, v85
    v_lshlrev_b32 v88, 5, v88
    v_lshlrev_b32 v85, 2, v85
    v_mov_b32 v90, 0
    v_mov_b32 v91, 0
    v_mov_b32 v92, 0
    v_mov_b32 v93, 0
    s_movk_i32 s46, 4096
    v_mov_b32 v94, 119808
    s_waitcnt lgkmcnt(0)
    s_add_u32 s20, s20, 1
    v_mov_b32 v86, s20
    v_lshrrev_b32 v87, v87, v86
    v_cndmask_b32 v89, 0, v86, vcc
    v_add_u32 v89, v89, v87
    v_and_or_b32 v88, v89, 31, v88
    s_waitcnt vmcnt(12)
    ds_read_b128 v[44:47], v95 offset:0
    ds_read_b128 v[48:51], v95 offset:128
    ds_read_b128 v[52:55], v95 offset:256
    ds_read_b128 v[56:59], v95 offset:384
    ds_read_b128 v[60:63], v95 offset:512
    ds_read_b128 v[64:67], v95 offset:640
    ds_read_b128 v[68:71], v95 offset:768
    ds_read_b128 v[72:75], v95 offset:896
    ds_read_b128 v[76:79], v95 offset:1024
    s_waitcnt lgkmcnt(0)
    s_waitcnt vmcnt(11)
    v_dot2c_f32_bf16 v90, v8, v44
    v_dot2c_f32_bf16 v91, v9, v45
    v_dot2c_f32_bf16 v92, v10, v46
    v_dot2c_f32_bf16 v93, v11, v47
    s_waitcnt vmcnt(10)
    v_dot2c_f32_bf16 v90, v12, v48
    v_dot2c_f32_bf16 v91, v13, v49
    v_dot2c_f32_bf16 v92, v14, v50
    v_dot2c_f32_bf16 v93, v15, v51
    s_waitcnt vmcnt(9)
    v_dot2c_f32_bf16 v90, v16, v52
    v_dot2c_f32_bf16 v91, v17, v53
    v_dot2c_f32_bf16 v92, v18, v54
    v_dot2c_f32_bf16 v93, v19, v55
    s_waitcnt vmcnt(8)
    v_dot2c_f32_bf16 v90, v20, v56
    v_dot2c_f32_bf16 v91, v21, v57
    v_dot2c_f32_bf16 v92, v22, v58
    v_dot2c_f32_bf16 v93, v23, v59
    s_waitcnt vmcnt(7)
    v_dot2c_f32_bf16 v90, v24, v60
    v_dot2c_f32_bf16 v91, v25, v61
    v_dot2c_f32_bf16 v92, v26, v62
    v_dot2c_f32_bf16 v93, v27, v63
    s_waitcnt vmcnt(6)
    v_dot2c_f32_bf16 v90, v28, v64
    v_dot2c_f32_bf16 v91, v29, v65
    v_dot2c_f32_bf16 v92, v30, v66
    v_dot2c_f32_bf16 v93, v31, v67
    s_waitcnt vmcnt(5)
    v_dot2c_f32_bf16 v90, v32, v68
    v_dot2c_f32_bf16 v91, v33, v69
    v_dot2c_f32_bf16 v92, v34, v70
    v_dot2c_f32_bf16 v93, v35, v71
    s_waitcnt vmcnt(4)
    v_dot2c_f32_bf16 v90, v36, v72
    v_dot2c_f32_bf16 v91, v37, v73
    v_dot2c_f32_bf16 v92, v38, v74
    v_dot2c_f32_bf16 v93, v39, v75
    s_waitcnt vmcnt(3)
    v_dot2c_f32_bf16 v90, v40, v76
    v_dot2c_f32_bf16 v91, v41, v77
    v_dot2c_f32_bf16 v92, v42, v78
    v_dot2c_f32_bf16 v93, v43, v79
    s_nop 2
    v_add_f32 v4, v90, v91
    v_add_f32 v6, v92, v93
    v_add_f32 v4, v4, v6
    s_nop 1
    v_add_f32_dpp v4, v4, v4 quad_perm:[1,0,3,2] row_mask:0xf bank_mask:0xf
    s_nop 1
    v_add_f32_dpp v4, v4, v4 quad_perm:[2,3,0,1] row_mask:0xf bank_mask:0xf
    s_nop 1
    v_add_f32_dpp v4, v4, v4 row_half_mirror row_mask:0xf bank_mask:0xf
    v_cvt_pk_bf16_f32 v5, v4, v4
    v_cmp_o_f32 vcc, v4, v4
    v_ashrrev_i32 v6, 31, v5
    v_or_b32 v6, 0x80000000, v6
    v_xor_b32 v6, v6, v5
    v_cndmask_b32 v6, 0, v6, vcc
    v_and_b32 v6, 0xffff0000, v6
    v_or_b32 v6, v6, v88
    s_mov_b32 exec_lo, 0x01010101
    s_mov_b32 exec_hi, 0x01010101
    s_waitcnt vmcnt(0)
    buffer_store_dword v6, v85, s[28:31], s46 offen sc1
    ds_write_b32 v94, v86
    s_mov_b64 exec, -1
    s_cmp_ge_u32 s2, 112
    s_cbranch_scc1 DOWNL
    s_waitcnt lgkmcnt(0)
    s_barrier
    s_setprio 0
    v_lshrrev_b32 v85, 2, v85
    v_mov_b32 v82, 0x207
    v_cmp_class_f32 vcc, v4, v82
    s_barrier
R_CHK:
    s_cbranch_vccnz R_SLOW
R_COPY:
    s_barrier
R_COPY2:
    v_mov_b32 v80, 119824
    ds_read_b128 v[44:47], v80
    ds_read_b128 v[48:51], v80 offset:16
    s_waitcnt lgkmcnt(0)
    v_cmpx_ne_u32 vcc, v85, v44
    v_cmpx_ne_u32 vcc, v85, v45
    v_cmpx_ne_u32 vcc, v85, v46
    v_cmpx_ne_u32 vcc, v85, v47
    v_cmpx_ne_u32 vcc, v85, v48
    v_cmpx_ne_u32 vcc, v85, v49
    v_cmpx_ne_u32 vcc, v85, v50
    v_cmpx_ne_u32 vcc, v85, v51
    s_nop 4
    s_cbranch_execz R_END
    global_store_dwordx4 v3, v[8:11], s[14:15] offset:0 sc1
    global_store_dwordx4 v3, v[12:15], s[14:15] offset:128 sc1
    global_store_dwordx4 v3, v[16:19], s[14:15] offset:256 sc1
    global_store_dwordx4 v3, v[20:23], s[14:15] offset:384 sc1
    global_store_dwordx4 v3, v[24:27], s[14:15] offset:512 sc1
    global_store_dwordx4 v3, v[28:31], s[14:15] offset:640 sc1
    global_store_dwordx4 v3, v[32:35], s[14:15] offset:768 sc1
    global_store_dwordx4 v3, v[36:39], s[14:15] offset:896 sc1
    global_store_dwordx4 v3, v[40:43], s[14:15] offset:1024 sc1
R_END:
END0:
    s_endpgm
HELPER:
    s_cmp_eq_u32 s3, 4
    s_cbranch_scc1 PREF
    s_add_u32 s47, s3, 1
    s_mul_i32 s47, s47, 112
    s_add_u32 s47, s47, s2
    s_cmp_ge_u32 s47, 256
    s_cbranch_scc1 END0
    v_mul_u32_u24 v3, 1152, v1
    s_mul_i32 s50, s47, 9216
    v_add3_u32 v3, v3, v2, s50
    v_lshl_add_u32 v85, s47, 3, v1
    s_waitcnt lgkmcnt(0)
    v_mov_b32 v4, 0
    v_mov_b32 v82, 0x207
    s_barrier
    s_barrier
    global_load_dwordx4 v[8:11], v3, s[4:5] offset:0
    global_load_dwordx4 v[12:15], v3, s[4:5] offset:128
    global_load_dwordx4 v[16:19], v3, s[4:5] offset:256
    global_load_dwordx4 v[20:23], v3, s[4:5] offset:384
    global_load_dwordx4 v[24:27], v3, s[4:5] offset:512
    global_load_dwordx4 v[28:31], v3, s[4:5] offset:640
    global_load_dwordx4 v[32:35], v3, s[4:5] offset:768
    global_load_dwordx4 v[36:39], v3, s[4:5] offset:896
    global_load_dwordx4 v[40:43], v3, s[4:5] offset:1024
    s_waitcnt vmcnt(8)
    v_dot2c_f32_bf16 v4, v8, v8
    v_dot2c_f32_bf16 v4, v9, v9
    v_dot2c_f32_bf16 v4, v10, v10
    v_dot2c_f32_bf16 v4, v11, v11
    s_waitcnt vmcnt(7)
    v_dot2c_f32_bf16 v4, v12, v12
    v_dot2c_f32_bf16 v4, v13, v13
    v_dot2c_f32_bf16 v4, v14, v14
    v_dot2c_f32_bf16 v4, v15, v15
    s_waitcnt vmcnt(6)
    v_dot2c_f32_bf16 v4, v16, v16
    v_dot2c_f32_bf16 v4, v17, v17
    v_dot2c_f32_bf16 v4, v18, v18
    v_dot2c_f32_bf16 v4, v19, v19
    s_waitcnt vmcnt(5)
    v_dot2c_f32_bf16 v4, v20, v20
    v_dot2c_f32_bf16 v4, v21, v21
    v_dot2c_f32_bf16 v4, v22, v22
    v_dot2c_f32_bf16 v4, v23, v23
    s_waitcnt vmcnt(4)
    v_dot2c_f32_bf16 v4, v24, v24
    v_dot2c_f32_bf16 v4, v25, v25
    v_dot2c_f32_bf16 v4, v26, v26
    v_dot2c_f32_bf16 v4, v27, v27
    s_waitcnt vmcnt(3)
    v_dot2c_f32_bf16 v4, v28, v28
    v_dot2c_f32_bf16 v4, v29, v29
    v_dot2c_f32_bf16 v4, v30, v30
    v_dot2c_f32_bf16 v4, v31, v31
    s_waitcnt vmcnt(2)
    v_dot2c_f32_bf16 v4, v32, v32
    v_dot2c_f32_bf16 v4, v33, v33
    v_dot2c_f32_bf16 v4, v34, v34
    v_dot2c_f32_bf16 v4, v35, v35
    s_waitcnt vmcnt(1)
    v_dot2c_f32_bf16 v4, v36, v36
    v_dot2c_f32_bf16 v4, v37, v37
    v_dot2c_f32_bf16 v4, v38, v38
    v_dot2c_f32_bf16 v4, v39, v39
    s_waitcnt vmcnt(0)
    v_dot2c_f32_bf16 v4, v40, v40
    v_dot2c_f32_bf16 v4, v41, v41
    v_dot2c_f32_bf16 v4, v42, v42
    v_dot2c_f32_bf16 v4, v43, v43
    s_nop 2
    v_cmp_class_f32 vcc, v4, v82
    s_branch R_CHK
PREF:
    s_lshr_b32 s44, s2, 3
    s_lshl_b32 s44, s44, 6
    s_and_b32 s45, s2, 7
    s_mul_i32 s46, s45, 663552
    s_mul_i32 s45, s45, 1152
    v_add_u32 v2, s44, v0
    v_add_u32 v4, 0, v2
    v_mul_u32_u24 v5, 7282, v4
    v_lshrrev_b32 v5, 16, v5
    v_mul_u32_u24 v6, 8064, v5
    v_lshl_add_u32 v4, v4, 7, v6
    v_add_u32 v4, 2359296, v4
    v_add_u32 v8, s45, v4
    s_lshr_b32 s47, s2, 3
    s_mul_i32 s47, s47, 19
    v_subrev_u32 v26, 19, v0
    v_min_u32 v26, v26, v0
    v_add_u32 v26, s47, v26
    v_mul_u32_u24 v26, 9216, v26
    v_cmp_lt_u32 vcc, 18, v0
    v_add_u32 v27, 1024, v26
    s_nop 0
    v_cndmask_b32 v26, v26, v27, vcc
    s_waitcnt lgkmcnt(0)
    s_load_dwordx2 s[20:21], s[18:19], 0
    s_lshr_b32 s47, s8, 7
    s_and_b32 s48, s2, 7
    s_add_u32 s47, s47, s48
    s_sub_u32 s47, 3, s47
    s_and_b32 s47, s47, 7
    s_cmp_eq_u32 s47, 0
    s_cselect_b32 s48, 38, 19
    s_bfm_b64 s[48:49], s48, 0
    s_lshl_b32 s47, s47, 7
    s_add_u32 s47, s47, s45
    s_mov_b32 s32, s8
    s_and_b32 s33, s9, 0xffff
    s_mov_b32 s34, 5308416
    s_mov_b32 s35, 0x20000
    s_mov_b32 s36, s10
    s_and_b32 s37, s11, 0xffff
    s_mov_b32 s38, 5308416
    s_mov_b32 s39, 0x20000
    s_mov_b64 exec, s[48:49]
    buffer_load_dword v24, v26, s[32:35], s47 offen
    buffer_load_dword v24, v26, s[36:39], s47 offen
    s_mov_b64 exec, -1
    s_waitcnt lgkmcnt(0)
    buffer_load_dword v24, v8, s[32:35], 0 offen
    buffer_load_dword v24, v8, s[36:39], 0 offen
    s_mov_b32 s40, s12
    s_and_b32 s41, s13, 0xffff
    s_mov_b32 s42, 5308416
    s_mov_b32 s43, 0x20000
    s_mov_b32 s28, s18
    s_and_b32 s29, s19, 0xffff
    s_mov_b32 s30, 4194304
    s_mov_b32 s31, 0x20000
    v_add_u32 v4, 896, v2
    v_mul_u32_u24 v5, 7282, v4
    v_lshrrev_b32 v5, 16, v5
    v_mul_u32_u24 v6, 8064, v5
    v_lshl_add_u32 v4, v4, 7, v6
    v_add_u32 v4, 2359296, v4
    v_add_u32 v9, s45, v4
    v_add_u32 v4, 1792, v2
    v_mul_u32_u24 v5, 7282, v4
    v_lshrrev_b32 v5, 16, v5
    v_mul_u32_u24 v6, 8064, v5
    v_lshl_add_u32 v4, v4, 7, v6
    v_add_u32 v4, 2359296, v4
    v_add_u32 v10, s45, v4
    v_add_u32 v4, 2688, v2
    v_mul_u32_u24 v5, 7282, v4
    v_lshrrev_b32 v5, 16, v5
    v_mul_u32_u24 v6, 8064, v5
    v_lshl_add_u32 v4, v4, 7, v6
    v_add_u32 v4, 2359296, v4
    v_add_u32 v11, s45, v4
    v_add_u32 v4, 0, v2
    v_add_u32 v5, 0, v4
    v_lshlrev_b32 v16, 7, v5
    v_add_u32 v4, 896, v2
    v_add_u32 v5, 0, v4
    v_lshlrev_b32 v17, 7, v5
    v_add_u32 v4, 1792, v2
    v_add_u32 v5, 0, v4
    v_cmp_gt_u32 vcc, 2016, v4
    v_add_u32 v6, 576, v4
    s_nop 0
    v_cndmask_b32 v5, v6, v5, vcc
    v_lshlrev_b32 v18, 7, v5
    v_add_u32 v4, 2688, v2
    v_add_u32 v5, 576, v4
    v_lshlrev_b32 v19, 7, v5
    v_add_u32 v4, 3584, v2
    v_add_u32 v5, 576, v4
    v_cmp_gt_u32 vcc, 4032, v4
    v_add_u32 v6, 4294965280, v4
    s_nop 0
    v_cndmask_b32 v5, v6, v5, vcc
    v_lshlrev_b32 v20, 7, v5
    v_add_u32 v4, 4480, v2
    v_add_u32 v5, 4294965280, v4
    v_cmp_gt_u32 vcc, 4608, v4
    v_add_u32 v6, 0, v4
    s_nop 0
    v_cndmask_b32 v5, v6, v5, vcc
    v_lshlrev_b32 v21, 7, v5
    v_cmp_gt_u32 vcc, 5184, v4
    v_mov_b32 v5, 117440512
    s_nop 0
    v_cndmask_b32 v21, v5, v21, vcc
    s_barrier
    buffer_load_dword v24, v9, s[32:35], 0 offen
    buffer_load_dword v24, v9, s[36:39], 0 offen
    buffer_load_dword v24, v10, s[32:35], 0 offen
    buffer_load_dword v24, v10, s[36:39], 0 offen
    buffer_load_dword v24, v11, s[32:35], 0 offen
    buffer_load_dword v24, v11, s[36:39], 0 offen
    buffer_load_dword v24, v16, s[40:43], s46 offen
    buffer_load_dword v24, v17, s[40:43], s46 offen
    buffer_load_dword v24, v18, s[40:43], s46 offen
    buffer_load_dword v24, v19, s[40:43], s46 offen
    buffer_load_dword v24, v20, s[40:43], s46 offen
    buffer_load_dword v24, v21, s[40:43], s46 offen
    s_waitcnt vmcnt(0)
    s_lshl_b32 s44, s2, 12
    s_add_u32 s44, s44, 1507328
    s_mov_b32 s45, 4194304
    v_mov_b32 v5, 119808
    ds_read_b32 v6, v5
    v_lshlrev_b32 v4, 3, v0
    v_lshl_add_u32 v5, v0, 2, v5
    s_mov_b64 exec, 0xff
    s_waitcnt lgkmcnt(0)
T_WAIT:
    buffer_load_dwordx2 v[24:25], v4, s[28:31], s44 offen offset:640 sc1
    s_sub_u32 s45, s45, 1
    s_waitcnt vmcnt(0)
    v_cmp_ne_u32 vcc, v6, v24
    s_cbranch_vccz T_OK
    s_cbranch_scc0 T_WAIT
T_OK:
    ds_write_b32 v5, v25 offset:16
    s_barrier
    s_movk_i32 s45, 2000
    s_mov_b64 exec, 1
C_WAIT:
    buffer_load_dword v24, v4, s[28:31], s44 offen sc1
    s_sub_u32 s45, s45, 1
    s_waitcnt vmcnt(0)
    v_cmp_ne_u32 vcc, -1, v24
    s_cbranch_vccnz C_GO
    s_cbranch_scc0 C_WAIT
C_GO:
    s_waitcnt lgkmcnt(0)
    s_barrier
    s_endpgm
FFN:
    s_sub_u32 s44, s2, 112
    s_and_b32 s23, s44, 7
    s_lshr_b32 s61, s44, 3
    s_mul_i32 s22, s23, 18
    s_add_u32 s22, s22, s61
    v_lshrrev_b32 v2, 2, v0
    v_mul_u32_u24 v2, 9216, v2
    s_lshl_b32 s44, s22, 6
    v_and_b32 v3, 3, v0
    v_lshrrev_b32 v4, 5, v0
    v_xor_b32 v3, v3, v4
    s_and_b32 s45, s3, 1
    s_lshl_b32 s46, s45, 1
    v_xor_b32 v3, s46, v3
    v_lshlrev_b32 v3, 4, v3
    v_add3_u32 v3, v3, v2, s44
    s_lshr_b32 s46, s3, 1
    s_and_b32 s47, s22, 1
    s_mul_i32 s47, s47, 8
    s_add_u32 s48, s46, s47
    s_sub_u32 s49, 8, s47
    s_add_u32 s49, s49, s46
    s_add_u32 s50, s46, 16
    s_mul_i32 s51, s45, 36864
    s_cmp_eq_u32 s45, 0
    s_waitcnt lgkmcnt(0)
    s_load_dwordx2 s[20:21], s[18:19], 0
    s_cselect_b32 s32, s8, s10
    s_cselect_b32 s33, s9, s11
    s_and_b32 s33, s33, 0xffff
    s_mov_b32 s34, 5308416
    s_mov_b32 s35, 0x20000
    s_mul_i32 s54, s48, 147456
    s_lshl_b32 s55, s48, 10
    s_add_u32 m0, s55, s51
    s_waitcnt lgkmcnt(0)
    buffer_load_dwordx4 v3, s[32:35], s54 offen lds
    s_add_u32 m0, m0, 2048
    s_add_u32 s54, s54, 2*147456
    buffer_load_dwordx4 v3, s[32:35], s54 offen lds
    s_add_u32 m0, m0, 2048
    s_add_u32 s54, s54, 2*147456
    buffer_load_dwordx4 v3, s[32:35], s54 offen lds
    s_mov_b32 s28, s18
    s_and_b32 s29, s19, 0xffff
    s_mov_b32 s30, 4194304
    s_mov_b32 s31, 0x20000
    s_cmp_ge_u32 s61, 9
    s_cselect_b32 s45, 9, 0
    s_sub_u32 s61, s61, s45
    v_and_b32 v7, 7, v0
    v_mov_b32 v33, 119808
    v_lshrrev_b32 v12, 4, v0
    v_bfe_u32 v13, v0, 2, 2
    v_bfe_u32 v14, v0, 1, 1
    v_and_b32 v15, 1, v0
    v_lshlrev_b32 v16, 3, v12
    v_add_u32 v16, v16, v13
    v_lshlrev_b32 v17, 7, v16
    v_lshlrev_b32 v16, 6, v16
    v_mul_u32_u24 v18, 36864, v14
    v_add_u32 v16, v16, v18
    v_and_b32 v18, 1, v12
    v_lshl_add_u32 v19, v14, 1, v18
    v_xor_b32 v19, s3, v19
    v_lshl_add_u32 v16, v19, 4, v16
    v_lshl_add_u32 v16, v15, 3, v16
    v_lshrrev_b32 v19, 1, v13
    v_lshl_add_u32 v19, v18, 1, v19
    v_xor_b32 v19, s3, v19
    v_lshl_add_u32 v17, v19, 5, v17
    v_and_b32 v19, 3, v0
    v_lshl_add_u32 v17, v19, 3, v17
    v_add_u32 v17, 73728, v17
    v_lshlrev_b32 v18, 2, v18
    v_xor_b32 v18, v18, v7
    v_lshlrev_b32 v18, 4, v18
    v_lshl_add_u32 v18, v12, 7, v18
    v_add_u32 v18, 110592, v18
    v_bfe_u32 v19, v0, 3, 1
    v_lshl_add_u32 v18, v19, 9, v18
    v_lshlrev_b32 v19, 4, v7
    v_and_b32 v28, 1, v12
    v_lshrrev_b32 v29, 5, v0
    v_lshl_add_u32 v28, v28, 1, v29
    v_lshl_add_u32 v28, v28, 2, v19
    s_lshl_b32 s52, s2, 12
    s_add_u32 s52, s52, 1048576
    s_lshl_b32 s44, s3, 7
    s_add_u32 s56, s52, s44
    s_lshl_b32 s44, s61, 15
    s_sub_u32 s58, s52, s44
    s_lshl_b32 s44, s3, 6
    s_add_u32 s52, s52, s44
    v_lshlrev_b32 v29, 8, v7
    v_lshl_add_u32 v29, v12, 4, v29
    v_lshl_add_u32 v31, v12, 7, v19
    v_bfe_u32 v30, v0, 3, 1
    v_lshl_add_u32 v30, v30, 15, v31
    s_waitcnt lgkmcnt(0)
    s_add_u32 s20, s20, 1
    s_mov_b32 s45, 4194304
L_PUB:
    ds_read_b32 v35, v33
    s_sub_u32 s45, s45, 1
    s_waitcnt lgkmcnt(0)
    v_cmp_eq_u32 vcc, s20, v35
    s_cbranch_vccnz L_PUB_OK
    s_cbranch_scc0 L_PUB
L_PUB_OK:
    s_add_u32 m0, m0, 2048
    s_add_u32 s54, s54, 2*147456
    buffer_load_dwordx4 v3, s[32:35], s54 offen lds
    s_mul_i32 s54, s49, 147456
    s_lshl_b32 s55, s49, 10
    s_add_u32 m0, s55, s51
    s_nop 0
    buffer_load_dwordx4 v3, s[32:35], s54 offen lds
    s_add_u32 m0, m0, 2048
    s_add_u32 s54, s54, 2*147456
    buffer_load_dwordx4 v3, s[32:35], s54 offen lds
    s_add_u32 m0, m0, 2048
    s_add_u32 s54, s54, 2*147456
    buffer_load_dwordx4 v3, s[32:35], s54 offen lds
    s_add_u32 m0, m0, 2048
    s_add_u32 s54, s54, 2*147456
    buffer_load_dwordx4 v3, s[32:35], s54 offen lds
    s_mul_i32 s54, s50, 147456
    s_lshl_b32 s55, s50, 10
    s_add_u32 m0, s55, s51
    s_nop 0
    buffer_load_dwordx4 v3, s[32:35], s54 offen lds
    s_add_u32 m0, m0, 2048
    s_add_u32 s54, s54, 2*147456
    buffer_load_dwordx4 v3, s[32:35], s54 offen lds
    s_waitcnt vmcnt(0)
    s_barrier
    s_barrier
LP10:
    s_add_u32 m0, m0, 2048
    s_add_u32 s54, s54, 2*147456
    buffer_load_dwordx4 v3, s[32:35], s54 offen lds
    s_add_u32 m0, m0, 2048
    s_add_u32 s54, s54, 2*147456
    buffer_load_dwordx4 v3, s[32:35], s54 offen lds
    s_add_u32 m0, m0, 2048
    s_add_u32 s54, s54, 2*147456
    buffer_load_dwordx4 v3, s[32:35], s54 offen lds
    s_add_u32 m0, m0, 2048
    s_add_u32 s54, s54, 2*147456
    buffer_load_dwordx4 v3, s[32:35], s54 offen lds
    s_add_u32 m0, m0, 2048
    s_add_u32 s54, s54, 2*147456
    buffer_load_dwordx4 v3, s[32:35], s54 offen lds
    s_add_u32 m0, m0, 2048
    s_add_u32 s54, s54, 2*147456
    buffer_load_dwordx4 v3, s[32:35], s54 offen lds
    s_add_u32 m0, m0, 2048
    s_add_u32 s54, s54, 2*147456
    buffer_load_dwordx4 v3, s[32:35], s54 offen lds
    s_add_u32 m0, m0, 2048
    s_add_u32 s54, s54, 2*147456
    buffer_load_dwordx4 v3, s[32:35], s54 offen lds
    s_branch TAIL
.p2align 12
TAIL:
    s_waitcnt vmcnt(0)
    s_setprio 2
    s_barrier
    ds_read_b64_tr_b16 v[64:65], v16 offset:0
    ds_read_b64_tr_b16 v[66:67], v16 offset:256
    ds_read_b64_tr_b16 v[68:69], v16 offset:2048
    ds_read_b64_tr_b16 v[70:71], v16 offset:2304
    ds_read_b64_tr_b16 v[72:73], v16 offset:4096
    ds_read_b64_tr_b16 v[74:75], v16 offset:4352
    ds_read_b64_tr_b16 v[76:77], v16 offset:6144
    ds_read_b64_tr_b16 v[78:79], v16 offset:6400
    ds_read_b64_tr_b16 v[80:81], v16 offset:8192
    ds_read_b64_tr_b16 v[82:83], v16 offset:8448
    ds_read_b64_tr_b16 v[84:85], v16 offset:10240
    ds_read_b64_tr_b16 v[86:87], v16 offset:10496
    ds_read_b64_tr_b16 v[88:89], v16 offset:12288
    ds_read_b64_tr_b16 v[90:91], v16 offset:12544
    ds_read_b64_tr_b16 v[92:93], v16 offset:14336
    ds_read_b64_tr_b16 v[94:95], v16 offset:14592
    ds_read_b64_tr_b16 v[96:97], v16 offset:16384
    ds_read_b64_tr_b16 v[98:99], v16 offset:16640
    ds_read_b64_tr_b16 v[100:101], v16 offset:18432
    ds_read_b64_tr_b16 v[102:103], v16 offset:18688
    ds_read_b64_tr_b16 v[104:105], v16 offset:20480
    ds_read_b64_tr_b16 v[106:107], v16 offset:20736
    ds_read_b64_tr_b16 v[108:109], v16 offset:22528
    ds_read_b64_tr_b16 v[110:111], v16 offset:22784
    ds_read_b64_tr_b16 v[112:113], v16 offset:24576
    ds_read_b64_tr_b16 v[114:115], v16 offset:24832
    ds_read_b64_tr_b16 v[116:117], v16 offset:26624
    ds_read_b64_tr_b16 v[118:119], v16 offset:26880
    ds_read_b64_tr_b16 v[120:121], v16 offset:28672
    ds_read_b64_tr_b16 v[122:123], v16 offset:28928
    ds_read_b64_tr_b16 v[124:125], v16 offset:30720
    ds_read_b64_tr_b16 v[126:127], v16 offset:30976
    ds_read_b64_tr_b16 v[128:129], v16 offset:32768
    ds_read_b64_tr_b16 v[130:131], v16 offset:33024
    ds_read_b64_tr_b16 v[132:133], v16 offset:34816
    ds_read_b64_tr_b16 v[134:135], v16 offset:35072
    s_mov_b32 s48, 4194304
    s_waitcnt lgkmcnt(0)
    s_barrier
    ds_read_b128 v[172:175], v18 offset:0
    ds_read_b128 v[176:179], v18 offset:1024
    ds_read_b128 v[180:183], v18 offset:2048
    ds_read_b128 v[184:187], v18 offset:3072
    ds_read_b128 v[188:191], v18 offset:4096
    ds_read_b128 v[192:195], v18 offset:5120
    ds_read_b128 v[196:199], v18 offset:6144
    ds_read_b128 v[200:203], v18 offset:7168
    ds_read_b128 v[204:207], v18 offset:8192
    ds_read_b32 v35, v33 offset:12
    s_waitcnt lgkmcnt(9)
    v_mfma_f32_16x16x32_bf16 v[20:23], v[64:67], v[172:175], 0
    v_mfma_f32_16x16x32_bf16 v[36:39], v[68:71], v[172:175], 0
    s_waitcnt lgkmcnt(8)
    v_mfma_f32_16x16x32_bf16 v[20:23], v[72:75], v[176:179], v[20:23]
    v_mfma_f32_16x16x32_bf16 v[36:39], v[76:79], v[176:179], v[36:39]
    s_waitcnt lgkmcnt(7)
    v_mfma_f32_16x16x32_bf16 v[20:23], v[80:83], v[180:183], v[20:23]
    v_mfma_f32_16x16x32_bf16 v[36:39], v[84:87], v[180:183], v[36:39]
    s_waitcnt lgkmcnt(6)
    v_mfma_f32_16x16x32_bf16 v[20:23], v[88:91], v[184:187], v[20:23]
    v_mfma_f32_16x16x32_bf16 v[36:39], v[92:95], v[184:187], v[36:39]
    s_waitcnt lgkmcnt(5)
    v_mfma_f32_16x16x32_bf16 v[20:23], v[96:99], v[188:191], v[20:23]
    v_mfma_f32_16x16x32_bf16 v[36:39], v[100:103], v[188:191], v[36:39]
    s_waitcnt lgkmcnt(4)
    v_mfma_f32_16x16x32_bf16 v[20:23], v[104:107], v[192:195], v[20:23]
    v_mfma_f32_16x16x32_bf16 v[36:39], v[108:111], v[192:195], v[36:39]
    s_waitcnt lgkmcnt(3)
    v_mfma_f32_16x16x32_bf16 v[20:23], v[112:115], v[196:199], v[20:23]
    v_mfma_f32_16x16x32_bf16 v[36:39], v[116:119], v[196:199], v[36:39]
    s_waitcnt lgkmcnt(2)
    v_mfma_f32_16x16x32_bf16 v[20:23], v[120:123], v[200:203], v[20:23]
    v_mfma_f32_16x16x32_bf16 v[36:39], v[124:127], v[200:203], v[36:39]
    s_waitcnt lgkmcnt(1)
    v_mfma_f32_16x16x32_bf16 v[20:23], v[128:131], v[204:207], v[20:23]
    v_mfma_f32_16x16x32_bf16 v[36:39], v[132:135], v[204:207], v[36:39]
    s_waitcnt lgkmcnt(0)
    v_readfirstlane_b32 s49, v35
    s_nop 5
    v_add_f32_dpp v20, v36, v20 row_ror:8 row_mask:0xf bank_mask:0xf
    v_add_f32_dpp v21, v37, v21 row_ror:8 row_mask:0xf bank_mask:0xf
    v_add_f32_dpp v22, v38, v22 row_ror:8 row_mask:0xf bank_mask:0xf
    v_add_f32_dpp v23, v39, v23 row_ror:8 row_mask:0xf bank_mask:0xf
    v_cvt_pk_bf16_f32 v24, v20, v21
    v_cvt_pk_bf16_f32 v25, v22, v23
    s_nop 1
    v_permlane32_swap_b32 v24, v25
    v_lshlrev_b32 v26, 16, v24
    v_and_b32 v27, 0xffff0000, v24
    v_mul_f32 v20, 0xbfb8aa3b, v26
    v_mul_f32 v21, 0xbfb8aa3b, v27
    v_exp_f32 v20, v20
    v_exp_f32 v21, v21
    v_lshlrev_b32 v22, 16, v25
    v_add_f32 v20, 1.0, v20
    v_add_f32 v21, 1.0, v21
    v_rcp_f32 v20, v20
    v_rcp_f32 v21, v21
    v_and_b32 v23, 0xffff0000, v25
    v_mul_f32 v26, v26, v20
    v_mul_f32 v27, v27, v21
    v_cvt_pk_bf16_f32 v26, v26, v27
    v_and_b32 v27, 0xffff0000, v26
    v_lshlrev_b32 v26, 16, v26
    v_mul_f32 v26, v26, v22
    v_mul_f32 v27, v27, v23
    v_cvt_pk_bf16_f32 v26, v26, v27
    s_mov_b32 exec_lo, 0x00ff00ff
    s_mov_b32 exec_hi, 0x00ff00ff
    v_min_u32 v26, -2, v26
    s_cmp_lg_u32 s49, 0
    s_cbranch_scc1 H_FAR
    buffer_store_dword v26, v28, s[28:31], s56 offen
H_STD:
    s_mov_b64 exec, -1
    s_barrier
    buffer_load_dwordx4 v[172:175], v30, s[28:31], s58 offen sc1
    s_add_u32 s44, s58, 65536
    buffer_load_dwordx4 v[176:179], v30, s[28:31], s44 offen sc1
    s_add_u32 s44, s58, 131072
    buffer_load_dwordx4 v[180:183], v30, s[28:31], s44 offen sc1
    s_add_u32 s44, s58, 196608
    buffer_load_dwordx4 v[184:187], v30, s[28:31], s44 offen sc1
    s_add_u32 s44, s58, 262144
    buffer_load_dwordx4 v[188:191], v31, s[28:31], s44 offen sc1
    ds_read_b64_tr_b16 v[136:137], v17 offset:0
    ds_read_b64_tr_b16 v[138:139], v17 offset:512
    ds_read_b64_tr_b16 v[140:141], v17 offset:4096
    ds_read_b64_tr_b16 v[142:143], v17 offset:4608
    ds_read_b64_tr_b16 v[144:145], v17 offset:8192
    ds_read_b64_tr_b16 v[146:147], v17 offset:8704
    ds_read_b64_tr_b16 v[148:149], v17 offset:12288
    ds_read_b64_tr_b16 v[150:151], v17 offset:12800
    ds_read_b64_tr_b16 v[152:153], v17 offset:16384
    ds_read_b64_tr_b16 v[154:155], v17 offset:16896
    ds_read_b64_tr_b16 v[156:157], v17 offset:20480
    ds_read_b64_tr_b16 v[158:159], v17 offset:20992
    ds_read_b64_tr_b16 v[160:161], v17 offset:24576
    ds_read_b64_tr_b16 v[162:163], v17 offset:25088
    ds_read_b64_tr_b16 v[164:165], v17 offset:28672
    ds_read_b64_tr_b16 v[166:167], v17 offset:29184
    ds_read_b64_tr_b16 v[168:169], v17 offset:32768
    ds_read_b64_tr_b16 v[170:171], v17 offset:33280
H_CHK:
    s_waitcnt vmcnt(4)
    v_max3_u32 v8, v172, v173, v174
    v_max_u32 v8, v8, v175
    s_waitcnt vmcnt(3)
    v_max3_u32 v8, v8, v176, v177
    v_max3_u32 v8, v8, v178, v179
    s_waitcnt vmcnt(2)
    v_max3_u32 v8, v8, v180, v181
    v_max3_u32 v8, v8, v182, v183
    s_waitcnt vmcnt(1)
    v_max3_u32 v8, v8, v184, v185
    v_max3_u32 v8, v8, v186, v187
    s_waitcnt vmcnt(0)
    v_max3_u32 v8, v8, v188, v189
    v_max3_u32 v8, v8, v190, v191
    v_cmp_eq_u32 vcc, -1, v8
    s_waitcnt lgkmcnt(0)
    s_cbranch_vccnz H_RETRY
H_OK:
    s_mov_b64 exec, -1
    v_mfma_f32_16x16x32_bf16 v[64:67], v[136:139], v[172:175], 0
    v_mfma_f32_16x16x32_bf16 v[68:71], v[140:143], v[172:175], 0
    v_mfma_f32_16x16x32_bf16 v[64:67], v[144:147], v[176:179], v[64:67]
    v_mfma_f32_16x16x32_bf16 v[68:71], v[148:151], v[176:179], v[68:71]
    v_mfma_f32_16x16x32_bf16 v[64:67], v[152:155], v[180:183], v[64:67]
    v_mfma_f32_16x16x32_bf16 v[68:71], v[156:159], v[180:183], v[68:71]
    v_mfma_f32_16x16x32_bf16 v[64:67], v[160:163], v[184:187], v[64:67]
    v_mfma_f32_16x16x32_bf16 v[68:71], v[164:167], v[184:187], v[68:71]
    v_mfma_f32_16x16x32_bf16 v[64:67], v[168:171], v[188:191], v[64:67]
    s_nop 7
    v_add_f32_dpp v64, v68, v64 row_ror:8 row_mask:0xf bank_mask:0xf
    v_add_f32_dpp v65, v69, v65 row_ror:8 row_mask:0xf bank_mask:0xf
    v_add_f32_dpp v66, v70, v66 row_ror:8 row_mask:0xf bank_mask:0xf
    v_add_f32_dpp v67, v71, v67 row_ror:8 row_mask:0xf bank_mask:0xf
    s_mov_b32 exec_lo, 0x00ff00ff
    s_mov_b32 exec_hi, 0x00ff00ff
    buffer_store_dwordx4 v[64:67], v29, s[28:31], s52 offen offset:1024 sc1
    s_waitcnt vmcnt(0)
    s_barrier
    s_barrier
    buffer_store_dword v26, v28, s[28:31], s56 offen sc1
    s_endpgm
H_RETRY:
    s_sub_u32 s48, s48, 1
    s_cbranch_scc1 H_OK
    s_mov_b64 exec, vcc
    buffer_load_dwordx4 v[172:175], v30, s[28:31], s58 offen sc1
    s_add_u32 s44, s58, 65536
    buffer_load_dwordx4 v[176:179], v30, s[28:31], s44 offen sc1
    s_add_u32 s44, s58, 131072
    buffer_load_dwordx4 v[180:183], v30, s[28:31], s44 offen sc1
    s_add_u32 s44, s58, 196608
    buffer_load_dwordx4 v[184:187], v30, s[28:31], s44 offen sc1
    s_add_u32 s44, s58, 262144
    buffer_load_dwordx4 v[188:191], v31, s[28:31], s44 offen sc1
    s_branch H_CHK
H_FAR:
    buffer_store_dword v26, v28, s[28:31], s56 offen sc1
    s_branch H_STD
DOWNL:
    s_setprio 0
    s_barrier
    s_barrier
    v_mul_u32_u24 v50, 1152, v1
    v_and_b32 v51, 2, v1
    v_lshlrev_b32 v51, 4, v51
    v_xor_b32 v51, v51, v2
    v_add_u32 v50, v50, v51
    v_xor_b32 v51, 64, v50
    s_sub_u32 s22, s2, 112
    s_lshr_b32 s44, s22, 3
    s_cmp_ge_u32 s44, 9
    s_cselect_b32 s45, 9, 0
    s_sub_u32 s44, s44, s45
    s_lshl_b32 s57, s44, 7
    s_and_b32 s44, s22, 7
    s_mul_i32 s56, s44, 18
    s_add_u32 s56, s56, s45
    s_mul_i32 s56, s56, 32*1152
    s_add_u32 s57, s57, s56
    s_mov_b32 s36, s12
    s_and_b32 s37, s13, 0xffff
    s_mov_b32 s38, 5308416
    s_mov_b32 s39, 0x20000
    s_add_u32 s56, s57, 258048
    s_mov_b32 m0, 102400
    s_barrier
    buffer_load_dwordx4 v50, s[36:39], s56 offen lds
    s_add_u32 m0, m0, 1024
    s_add_u32 s56, s56, 9216
    buffer_load_dwordx4 v51, s[36:39], s56 offen lds
    s_add_u32 m0, m0, 1024
    s_add_u32 s56, s56, 9216
    buffer_load_dwordx4 v50, s[36:39], s56 offen lds
    s_add_u32 m0, m0, 1024
    s_add_u32 s56, s56, 9216
    buffer_load_dwordx4 v51, s[36:39], s56 offen lds
    s_add_u32 m0, m0, 1024
    s_add_u32 s56, s56, 9216
    buffer_load_dwordx4 v50, s[36:39], s56 offen lds
    s_add_u32 m0, m0, 1024
    s_add_u32 s56, s56, 9216
    buffer_load_dwordx4 v51, s[36:39], s56 offen lds
    s_add_u32 m0, m0, 1024
    s_add_u32 s56, s56, 9216
    buffer_load_dwordx4 v50, s[36:39], s56 offen lds
    s_add_u32 m0, m0, 1024
    s_add_u32 s56, s56, 9216
    buffer_load_dwordx4 v51, s[36:39], s56 offen lds
    s_mov_b32 m0, 73728
    s_nop 0
    s_barrier
    buffer_load_dwordx4 v50, s[36:39], s57 offen lds
    s_add_u32 m0, m0, 1024
    s_add_u32 s57, s57, 9216
    buffer_load_dwordx4 v51, s[36:39], s57 offen lds
    s_add_u32 m0, m0, 1024
    s_add_u32 s57, s57, 9216
    buffer_load_dwordx4 v50, s[36:39], s57 offen lds
    s_add_u32 m0, m0, 1024
    s_add_u32 s57, s57, 9216
    buffer_load_dwordx4 v51, s[36:39], s57 offen lds
    s_add_u32 m0, m0, 1024
    s_add_u32 s57, s57, 9216
    buffer_load_dwordx4 v50, s[36:39], s57 offen lds
    s_add_u32 m0, m0, 1024
    s_add_u32 s57, s57, 9216
    buffer_load_dwordx4 v51, s[36:39], s57 offen lds
    s_add_u32 m0, m0, 1024
    s_add_u32 s57, s57, 9216
    buffer_load_dwordx4 v50, s[36:39], s57 offen lds
    s_add_u32 m0, m0, 1024
    s_add_u32 s57, s57, 9216
    buffer_load_dwordx4 v51, s[36:39], s57 offen lds
    s_add_u32 m0, m0, 1024
    s_add_u32 s57, s57, 9216
    buffer_load_dwordx4 v50, s[36:39], s57 offen lds
    s_add_u32 m0, m0, 1024
    s_add_u32 s57, s57, 9216
    buffer_load_dwordx4 v51, s[36:39], s57 offen lds
    s_add_u32 m0, m0, 1024
    s_add_u32 s57, s57, 9216
    buffer_load_dwordx4 v50, s[36:39], s57 offen lds
    s_add_u32 m0, m0, 1024
    s_add_u32 s57, s57, 9216
    buffer_load_dwordx4 v51, s[36:39], s57 offen lds
    s_add_u32 m0, m0, 1024
    s_add_u32 s57, s57, 9216
    buffer_load_dwordx4 v50, s[36:39], s57 offen lds
    s_add_u32 m0, m0, 1024
    s_add_u32 s57, s57, 9216
    buffer_load_dwordx4 v51, s[36:39], s57 offen lds
    s_add_u32 m0, m0, 1024
    s_add_u32 s57, s57, 9216
    buffer_load_dwordx4 v50, s[36:39], s57 offen lds
    s_add_u32 m0, m0, 1024
    s_add_u32 s57, s57, 9216
    buffer_load_dwordx4 v51, s[36:39], s57 offen lds
    s_add_u32 m0, m0, 1024
    s_add_u32 s57, s57, 9216
    buffer_load_dwordx4 v50, s[36:39], s57 offen lds
    s_add_u32 m0, m0, 1024
    s_add_u32 s57, s57, 9216
    buffer_load_dwordx4 v51, s[36:39], s57 offen lds
    s_add_u32 m0, m0, 1024
    s_add_u32 s57, s57, 9216
    buffer_load_dwordx4 v50, s[36:39], s57 offen lds
    s_add_u32 m0, m0, 1024
    s_add_u32 s57, s57, 9216
    buffer_load_dwordx4 v51, s[36:39], s57 offen lds
    s_add_u32 m0, m0, 1024
    s_add_u32 s57, s57, 9216
    buffer_load_dwordx4 v50, s[36:39], s57 offen lds
    s_add_u32 m0, m0, 1024
    s_add_u32 s57, s57, 9216
    buffer_load_dwordx4 v51, s[36:39], s57 offen lds
    s_add_u32 m0, m0, 1024
    s_add_u32 s57, s57, 9216
    buffer_load_dwordx4 v50, s[36:39], s57 offen lds
    s_add_u32 m0, m0, 1024
    s_add_u32 s57, s57, 9216
    buffer_load_dwordx4 v51, s[36:39], s57 offen lds
    s_add_u32 m0, m0, 1024
    s_add_u32 s57, s57, 9216
    buffer_load_dwordx4 v50, s[36:39], s57 offen lds
    s_add_u32 m0, m0, 1024
    s_add_u32 s57, s57, 9216
    buffer_load_dwordx4 v51, s[36:39], s57 offen lds
    s_add_u32 m0, m0, 1024
    s_add_u32 s57, s57, 9216
    buffer_load_dwordx4 v50, s[36:39], s57 offen lds
    s_add_u32 m0, m0, 1024
    s_add_u32 s57, s57, 9216
    buffer_load_dwordx4 v51, s[36:39], s57 offen lds
    s_waitcnt vmcnt(0)
    s_barrier
    s_endpgm
R_SLOW:
    s_mov_b32 s44, 0x7f807f80
    s_mov_b32 s45, 0x00400040
    v_and_b32 v80, s44, v8
    v_add_u32 v80, 0x00800080, v80
    v_lshrrev_b32 v80, 9, v80
    v_and_or_b32 v8, v80, s45, v8
    v_and_b32 v80, s44, v9
    v_add_u32 v80, 0x00800080, v80
    v_lshrrev_b32 v80, 9, v80
    v_and_or_b32 v9, v80, s45, v9
    v_and_b32 v80, s44, v10
    v_add_u32 v80, 0x00800080, v80
    v_lshrrev_b32 v80, 9, v80
    v_and_or_b32 v10, v80, s45, v10
    v_and_b32 v80, s44, v11
    v_add_u32 v80, 0x00800080, v80
    v_lshrrev_b32 v80, 9, v80
    v_and_or_b32 v11, v80, s45, v11
    v_and_b32 v80, s44, v12
    v_add_u32 v80, 0x00800080, v80
    v_lshrrev_b32 v80, 9, v80
    v_and_or_b32 v12, v80, s45, v12
    v_and_b32 v80, s44, v13
    v_add_u32 v80, 0x00800080, v80
    v_lshrrev_b32 v80, 9, v80
    v_and_or_b32 v13, v80, s45, v13
    v_and_b32 v80, s44, v14
    v_add_u32 v80, 0x00800080, v80
    v_lshrrev_b32 v80, 9, v80
    v_and_or_b32 v14, v80, s45, v14
    v_and_b32 v80, s44, v15
    v_add_u32 v80, 0x00800080, v80
    v_lshrrev_b32 v80, 9, v80
    v_and_or_b32 v15, v80, s45, v15
    v_and_b32 v80, s44, v16
    v_add_u32 v80, 0x00800080, v80
    v_lshrrev_b32 v80, 9, v80
    v_and_or_b32 v16, v80, s45, v16
    v_and_b32 v80, s44, v17
    v_add_u32 v80, 0x00800080, v80
    v_lshrrev_b32 v80, 9, v80
    v_and_or_b32 v17, v80, s45, v17
    v_and_b32 v80, s44, v18
    v_add_u32 v80, 0x00800080, v80
    v_lshrrev_b32 v80, 9, v80
    v_and_or_b32 v18, v80, s45, v18
    v_and_b32 v80, s44, v19
    v_add_u32 v80, 0x00800080, v80
    v_lshrrev_b32 v80, 9, v80
    v_and_or_b32 v19, v80, s45, v19
    v_and_b32 v80, s44, v20
    v_add_u32 v80, 0x00800080, v80
    v_lshrrev_b32 v80, 9, v80
    v_and_or_b32 v20, v80, s45, v20
    v_and_b32 v80, s44, v21
    v_add_u32 v80, 0x00800080, v80
    v_lshrrev_b32 v80, 9, v80
    v_and_or_b32 v21, v80, s45, v21
    v_and_b32 v80, s44, v22
    v_add_u32 v80, 0x00800080, v80
    v_lshrrev_b32 v80, 9, v80
    v_and_or_b32 v22, v80, s45, v22
    v_and_b32 v80, s44, v23
    v_add_u32 v80, 0x00800080, v80
    v_lshrrev_b32 v80, 9, v80
    v_and_or_b32 v23, v80, s45, v23
    v_and_b32 v80, s44, v24
    v_add_u32 v80, 0x00800080, v80
    v_lshrrev_b32 v80, 9, v80
    v_and_or_b32 v24, v80, s45, v24
    v_and_b32 v80, s44, v25
    v_add_u32 v80, 0x00800080, v80
    v_lshrrev_b32 v80, 9, v80
    v_and_or_b32 v25, v80, s45, v25
    v_and_b32 v80, s44, v26
    v_add_u32 v80, 0x00800080, v80
    v_lshrrev_b32 v80, 9, v80
    v_and_or_b32 v26, v80, s45, v26
    v_and_b32 v80, s44, v27
    v_add_u32 v80, 0x00800080, v80
    v_lshrrev_b32 v80, 9, v80
    v_and_or_b32 v27, v80, s45, v27
    v_and_b32 v80, s44, v28
    v_add_u32 v80, 0x00800080, v80
    v_lshrrev_b32 v80, 9, v80
    v_and_or_b32 v28, v80, s45, v28
    v_and_b32 v80, s44, v29
    v_add_u32 v80, 0x00800080, v80
    v_lshrrev_b32 v80, 9, v80
    v_and_or_b32 v29, v80, s45, v29
    v_and_b32 v80, s44, v30
    v_add_u32 v80, 0x00800080, v80
    v_lshrrev_b32 v80, 9, v80
    v_and_or_b32 v30, v80, s45, v30
    v_and_b32 v80, s44, v31
    v_add_u32 v80, 0x00800080, v80
    v_lshrrev_b32 v80, 9, v80
    v_and_or_b32 v31, v80, s45, v31
    v_and_b32 v80, s44, v32
    v_add_u32 v80, 0x00800080, v80
    v_lshrrev_b32 v80, 9, v80
    v_and_or_b32 v32, v80, s45, v32
    v_and_b32 v80, s44, v33
    v_add_u32 v80, 0x00800080, v80
    v_lshrrev_b32 v80, 9, v80
    v_and_or_b32 v33, v80, s45, v33
    v_and_b32 v80, s44, v34
    v_add_u32 v80, 0x00800080, v80
    v_lshrrev_b32 v80, 9, v80
    v_and_or_b32 v34, v80, s45, v34
    v_and_b32 v80, s44, v35
    v_add_u32 v80, 0x00800080, v80
    v_lshrrev_b32 v80, 9, v80
    v_and_or_b32 v35, v80, s45, v35
    v_and_b32 v80, s44, v36
    v_add_u32 v80, 0x00800080, v80
    v_lshrrev_b32 v80, 9, v80
    v_and_or_b32 v36, v80, s45, v36
    v_and_b32 v80, s44, v37
    v_add_u32 v80, 0x00800080, v80
    v_lshrrev_b32 v80, 9, v80
    v_and_or_b32 v37, v80, s45, v37
    v_and_b32 v80, s44, v38
    v_add_u32 v80, 0x00800080, v80
    v_lshrrev_b32 v80, 9, v80
    v_and_or_b32 v38, v80, s45, v38
    v_and_b32 v80, s44, v39
    v_add_u32 v80, 0x00800080, v80
    v_lshrrev_b32 v80, 9, v80
    v_and_or_b32 v39, v80, s45, v39
    v_and_b32 v80, s44, v40
    v_add_u32 v80, 0x00800080, v80
    v_lshrrev_b32 v80, 9, v80
    v_and_or_b32 v40, v80, s45, v40
    v_and_b32 v80, s44, v41
    v_add_u32 v80, 0x00800080, v80
    v_lshrrev_b32 v80, 9, v80
    v_and_or_b32 v41, v80, s45, v41
    v_and_b32 v80, s44, v42
    v_add_u32 v80, 0x00800080, v80
    v_lshrrev_b32 v80, 9, v80
    v_and_or_b32 v42, v80, s45, v42
    v_and_b32 v80, s44, v43
    v_add_u32 v80, 0x00800080, v80
    v_lshrrev_b32 v80, 9, v80
    v_and_or_b32 v43, v80, s45, v43
    s_branch R_COPY
.p2align 12
SEL:
    s_waitcnt lgkmcnt(0)
    s_load_dwordx2 s[20:21], s[18:19], 0
    v_lshlrev_b32 v12, 4, v1
    v_lshrrev_b32 v14, 1, v1
    v_lshlrev_b32 v14, 12, v14
    v_and_b32 v3, 1, v1
    v_mul_u32_u24 v3, 294912, v3
    v_add3_u32 v14, v14, v3, v2
    v_and_b32 v2, 1, v0
    v_bfe_u32 v3, v0, 1, 1
    v_bfe_i32 v4, v0, 5, 1
    v_bfe_i32 v5, v0, 4, 1
    v_add_u32 v40, -1, v2
    v_add_u32 v41, -1, v3
    v_xor_b32 v42, v41, v4
    v_xor_b32 v43, v40, v4
    v_not_b32 v44, v4
    v_mov_b32 v45, v4
    v_xor_b32 v46, v41, v5
    v_xor_b32 v47, v40, v5
    v_not_b32 v48, v5
    v_mov_b32 v49, v5
    v_lshlrev_b32 v1, 4, v0
    v_lshlrev_b32 v2, 7, v0
    v_sub_u32 v2, 65504, v2
    v_mov_b32 v33, 119816
    s_mov_b32 s28, s18
    s_and_b32 s29, s19, 0xffff
    s_mov_b32 s30, 4194304
    s_mov_b32 s31, 0x20000
    s_mov_b32 s24, s4
    s_and_b32 s25, s5, 0xffff
    s_mov_b32 s26, 2359296
    s_mov_b32 s27, 0x20000
    s_mov_b32 s40, s14
    s_and_b32 s41, s15, 0xffff
    s_mov_b32 s42, 2359296
    s_mov_b32 s43, 0x20000
    s_movk_i32 s46, 4096
    s_movk_i32 s47, 8192
    s_mov_b32 s48, 4194304
    s_sub_u32 s22, s2, 112
    s_lshr_b32 s44, s22, 4
    s_lshl_b32 s60, s44, 15
    s_and_b32 s44, s22, 15
    s_lshl_b32 s44, s44, 7
    s_add_u32 s60, s60, s44
    s_add_u32 s60, s60, 1508352
    s_add_u32 s59, s60, 16384
    v_bfe_u32 v5, v0, 4, 1
    v_lshrrev_b32 v4, 5, v0
    v_lshl_add_u32 v5, v5, 1, v4
    v_and_b32 v4, 7, v0
    v_lshl_add_u32 v5, v4, 2, v5
    s_lshr_b32 s44, s22, 4
    s_lshl_b32 s44, s44, 1
    s_and_b32 s45, s22, 1
    s_add_u32 s44, s44, s45
    s_lshl_b32 s44, s44, 5
    v_add_u32 v5, s44, v5
    v_lshlrev_b32 v5, 1, v5
    s_bfe_u32 s55, s22, 0x30001
    s_lshr_b32 s44, s22, 3
    s_cmp_ge_u32 s44, 9
    s_cselect_b32 s45, 9, 0
    s_and_b32 s44, s22, 7
    s_lshl_b32 s45, s45, 3
    s_add_u32 s44, s44, s45
    s_lshl_b32 s58, s44, 12
    s_add_u32 s58, s58, 1507328
    v_lshrrev_b32 v36, 2, v0
    v_lshlrev_b32 v36, 15, v36
    v_and_b32 v37, 3, v0
    v_lshl_add_u32 v36, v37, 7, v36
    v_subrev_u32 v37, 36, v0
    v_cmp_gt_u32 vcc, 36, v0
    v_min_u32 v37, 8, v37
    v_lshlrev_b32 v37, 15, v37
    v_add_u32 v37, 512, v37
    v_cndmask_b32 v36, v37, v36, vcc
    s_getreg_b32 s23, hwreg(HW_REG_XCC_ID)
    s_waitcnt lgkmcnt(0)
    s_add_u32 s20, s20, 1
    s_addc_u32 s21, s21, 0
    s_lshr_b32 s44, s20, 5
    s_add_u32 s51, s44, s20
    s_lshr_b32 s44, s20, 10
    s_add_u32 s52, s44, s20
    s_lshr_b32 s44, s20, 15
    s_add_u32 s53, s44, s20
    s_and_b32 s50, s20, 31
    s_and_b32 s51, s51, 31
    s_and_b32 s52, s52, 31
    s_and_b32 s53, s53, 31
    s_sub_u32 s51, s51, 32
    s_sub_u32 s52, s52, 64
    s_sub_u32 s53, s53, 96
    s_movk_i32 s44, 0xe000
    v_add_u32 v96, s50, v2
    v_add_u32 v97, s51, v2
    v_add_u32 v98, s52, v2
    v_add_u32 v99, s53, v2
    v_add_u32 v100, s44, v96
    v_add_u32 v101, s44, v97
    v_add_u32 v102, s44, v98
    v_add_u32 v103, s44, v99
    v_add_u32 v104, s44, v100
    v_add_u32 v105, s44, v101
    v_add_u32 v106, s44, v102
    v_add_u32 v107, s44, v103
    v_add_u32 v108, s44, v104
    v_add_u32 v109, s44, v105
    v_add_u32 v110, s44, v106
    v_add_u32 v111, s44, v107
    v_add_u32 v112, s44, v108
    v_add_u32 v113, s44, v109
    v_add_u32 v114, s44, v110
    v_add_u32 v115, s44, v111
    v_add_u32 v116, s44, v112
    v_add_u32 v117, s44, v113
    v_add_u32 v118, s44, v114
    v_add_u32 v119, s44, v115
    v_add_u32 v120, s44, v116
    v_add_u32 v121, s44, v117
    v_add_u32 v122, s44, v118
    v_add_u32 v123, s44, v119
    v_add_u32 v124, s44, v120
    v_add_u32 v125, s44, v121
    v_add_u32 v126, s44, v122
    v_add_u32 v127, s44, v123
    v_lshlrev_b32 v52, 3, v0
    s_lshl_b32 s53, s2, 12
    s_add_u32 s53, s53, 1048576
    s_barrier
    buffer_load_dwordx4 v[64:67], v1, s[28:31], s46 offen offset:0 sc1
    buffer_load_dwordx4 v[68:71], v1, s[28:31], s46 offen offset:1024 sc1
    buffer_load_dwordx4 v[72:75], v1, s[28:31], s46 offen offset:2048 sc1
    buffer_load_dwordx4 v[76:79], v1, s[28:31], s46 offen offset:3072 sc1
    buffer_load_dwordx4 v[80:83], v1, s[28:31], s47 offen offset:0 sc1
    buffer_load_dwordx4 v[84:87], v1, s[28:31], s47 offen offset:1024 sc1
    buffer_load_dwordx4 v[88:91], v1, s[28:31], s47 offen offset:2048 sc1
    buffer_load_dwordx4 v[92:95], v1, s[28:31], s47 offen offset:3072 sc1
    s_waitcnt vmcnt(7)
    s_barrier
POLL:
    v_mov_b32 v6, 0
    v_mov_b32 v7, 0
    v_mov_b32 v8, 0
    s_waitcnt vmcnt(7)
    v_max3_u32 v9, v64, v65, v66
    v_med3_u32 v10, v64, v65, v66
    v_bitop3_b32 v8, v64, v96, v8 bitop3:0xbe
    v_med3_u32 v11, v6, v9, v67
    v_max3_u32 v6, v6, v9, v67
    v_bitop3_b32 v8, v65, v97, v8 bitop3:0xbe
    v_max3_u32 v7, v7, v10, v11
    v_bitop3_b32 v8, v66, v98, v8 bitop3:0xbe
    v_bitop3_b32 v8, v67, v99, v8 bitop3:0xbe
    s_waitcnt vmcnt(6)
    v_max3_u32 v9, v68, v69, v70
    v_med3_u32 v10, v68, v69, v70
    v_bitop3_b32 v8, v68, v100, v8 bitop3:0xbe
    v_med3_u32 v11, v6, v9, v71
    v_max3_u32 v6, v6, v9, v71
    v_bitop3_b32 v8, v69, v101, v8 bitop3:0xbe
    v_max3_u32 v7, v7, v10, v11
    v_bitop3_b32 v8, v70, v102, v8 bitop3:0xbe
    v_bitop3_b32 v8, v71, v103, v8 bitop3:0xbe
    s_waitcnt vmcnt(5)
    v_max3_u32 v9, v72, v73, v74
    v_med3_u32 v10, v72, v73, v74
    v_bitop3_b32 v8, v72, v104, v8 bitop3:0xbe
    v_med3_u32 v11, v6, v9, v75
    v_max3_u32 v6, v6, v9, v75
    v_bitop3_b32 v8, v73, v105, v8 bitop3:0xbe
    v_max3_u32 v7, v7, v10, v11
    v_bitop3_b32 v8, v74, v106, v8 bitop3:0xbe
    v_bitop3_b32 v8, v75, v107, v8 bitop3:0xbe
    s_waitcnt vmcnt(4)
    v_max3_u32 v9, v76, v77, v78
    v_med3_u32 v10, v76, v77, v78
    v_bitop3_b32 v8, v76, v108, v8 bitop3:0xbe
    v_med3_u32 v11, v6, v9, v79
    v_max3_u32 v6, v6, v9, v79
    v_bitop3_b32 v8, v77, v109, v8 bitop3:0xbe
    v_max3_u32 v7, v7, v10, v11
    v_bitop3_b32 v8, v78, v110, v8 bitop3:0xbe
    v_bitop3_b32 v8, v79, v111, v8 bitop3:0xbe
    s_waitcnt vmcnt(3)
    v_max3_u32 v9, v80, v81, v82
    v_med3_u32 v10, v80, v81, v82
    v_bitop3_b32 v8, v80, v112, v8 bitop3:0xbe
    v_med3_u32 v11, v6, v9, v83
    v_max3_u32 v6, v6, v9, v83
    v_bitop3_b32 v8, v81, v113, v8 bitop3:0xbe
    v_max3_u32 v7, v7, v10, v11
    v_bitop3_b32 v8, v82, v114, v8 bitop3:0xbe
    v_bitop3_b32 v8, v83, v115, v8 bitop3:0xbe
    s_waitcnt vmcnt(2)
    v_max3_u32 v9, v84, v85, v86
    v_med3_u32 v10, v84, v85, v86
    v_bitop3_b32 v8, v84, v116, v8 bitop3:0xbe
    v_med3_u32 v11, v6, v9, v87
    v_max3_u32 v6, v6, v9, v87
    v_bitop3_b32 v8, v85, v117, v8 bitop3:0xbe
    v_max3_u32 v7, v7, v10, v11
    v_bitop3_b32 v8, v86, v118, v8 bitop3:0xbe
    v_bitop3_b32 v8, v87, v119, v8 bitop3:0xbe
    s_waitcnt vmcnt(1)
    v_max3_u32 v9, v88, v89, v90
    v_med3_u32 v10, v88, v89, v90
    v_bitop3_b32 v8, v88, v120, v8 bitop3:0xbe
    v_med3_u32 v11, v6, v9, v91
    v_max3_u32 v6, v6, v9, v91
    v_bitop3_b32 v8, v89, v121, v8 bitop3:0xbe
    v_max3_u32 v7, v7, v10, v11
    v_bitop3_b32 v8, v90, v122, v8 bitop3:0xbe
    v_bitop3_b32 v8, v91, v123, v8 bitop3:0xbe
    s_waitcnt vmcnt(0)
    v_max3_u32 v9, v92, v93, v94
    v_med3_u32 v10, v92, v93, v94
    v_bitop3_b32 v8, v92, v124, v8 bitop3:0xbe
    v_med3_u32 v11, v6, v9, v95
    v_max3_u32 v6, v6, v9, v95
    v_bitop3_b32 v8, v93, v125, v8 bitop3:0xbe
    v_max3_u32 v7, v7, v10, v11
    v_bitop3_b32 v8, v94, v126, v8 bitop3:0xbe
    v_bitop3_b32 v8, v95, v127, v8 bitop3:0xbe
    v_and_b32 v8, 0xffff, v8
    v_cmp_ne_u32 vcc, 0, v8
    v_mov_b32 v53, v7
    s_sub_u32 s48, s48, 1
    s_cbranch_vccnz POLL_AGAIN
POLL_OK:
    buffer_load_dword v37, v36, s[28:31], s58 offen sc1
    v_mov_b32_dpp v9, v7 quad_perm:[1,0,3,2] row_mask:0xf bank_mask:0xf
    v_mov_b32_dpp v10, v6 quad_perm:[1,0,3,2] row_mask:0xf bank_mask:0xf
    v_med3_u32 v6, v6, v9, v40
    v_med3_u32 v7, v7, v10, v40
    v_max_u32 v9, v6, v7
    v_min_u32 v7, v6, v7
    s_nop 1
    v_mov_b32_dpp v6, v7 quad_perm:[3,2,1,0] row_mask:0xf bank_mask:0xf
    v_mov_b32_dpp v10, v9 quad_perm:[3,2,1,0] row_mask:0xf bank_mask:0xf
    v_med3_u32 v9, v9, v6, v42
    v_med3_u32 v7, v7, v10, v42
    s_nop 0
    v_mov_b32_dpp v6, v9 quad_perm:[1,0,3,2] row_mask:0xf bank_mask:0xf
    v_mov_b32_dpp v10, v7 quad_perm:[1,0,3,2] row_mask:0xf bank_mask:0xf
    v_med3_u32 v9, v9, v6, v43
    v_med3_u32 v7, v7, v10, v43
    v_med3_u32 v6, v9, v7, v44
    v_med3_u32 v7, v9, v7, v45
    v_mov_b32 v9, v6
    v_mov_b32 v10, v7
    s_nop 0
    v_permlane32_swap_b32 v6, v9
    v_permlane32_swap_b32 v7, v10
    v_max_u32 v6, v6, v9
    v_max_u32 v7, v7, v10
    s_nop 0
    v_mov_b32_dpp v9, v6 quad_perm:[2,3,0,1] row_mask:0xf bank_mask:0xf
    v_mov_b32_dpp v10, v7 quad_perm:[2,3,0,1] row_mask:0xf bank_mask:0xf
    v_med3_u32 v6, v6, v9, v46
    v_med3_u32 v7, v7, v10, v46
    s_nop 0
    v_mov_b32_dpp v9, v6 quad_perm:[1,0,3,2] row_mask:0xf bank_mask:0xf
    v_mov_b32_dpp v10, v7 quad_perm:[1,0,3,2] row_mask:0xf bank_mask:0xf
    v_med3_u32 v6, v6, v9, v47
    v_med3_u32 v7, v7, v10, v47
    v_med3_u32 v9, v6, v7, v48
    v_med3_u32 v7, v6, v7, v49
    v_mov_b32 v6, v9
    v_mov_b32 v10, v7
    s_nop 0
    v_permlane16_swap_b32 v9, v6
    v_permlane16_swap_b32 v7, v10
    v_max_u32 v9, v9, v6
    v_max_u32 v7, v7, v10
    s_nop 0
    v_mov_b32_dpp v6, v9 quad_perm:[2,3,0,1] row_mask:0xf bank_mask:0xf
    v_mov_b32_dpp v10, v7 quad_perm:[2,3,0,1] row_mask:0xf bank_mask:0xf
    v_med3_u32 v9, v9, v6, v41
    v_med3_u32 v7, v7, v10, v41
    s_nop 0
    v_mov_b32_dpp v6, v9 quad_perm:[1,0,3,2] row_mask:0xf bank_mask:0xf
    v_mov_b32_dpp v10, v7 quad_perm:[1,0,3,2] row_mask:0xf bank_mask:0xf
    v_med3_u32 v9, v9, v6, v40
    v_med3_u32 v7, v7, v10, v40
    v_max_u32 v6, v9, v7
    v_min_u32 v7, v9, v7
    s_nop 1
    v_max_u32_dpp v9, v7, v6 row_mirror row_mask:0xf bank_mask:0xf
    v_max_u32_dpp v7, v6, v7 row_mirror row_mask:0xf bank_mask:0xf
    s_nop 0
    v_mov_b32_dpp v6, v9 quad_perm:[2,3,0,1] row_mask:0xf bank_mask:0xf
    v_mov_b32_dpp v10, v7 quad_perm:[2,3,0,1] row_mask:0xf bank_mask:0xf
    v_med3_u32 v9, v9, v6, v41
    v_med3_u32 v7, v7, v10, v41
    s_nop 0
    v_mov_b32_dpp v6, v9 quad_perm:[1,0,3,2] row_mask:0xf bank_mask:0xf
    v_mov_b32_dpp v10, v7 quad_perm:[1,0,3,2] row_mask:0xf bank_mask:0xf
    v_med3_u32 v9, v9, v6, v40
    v_med3_u32 v7, v7, v10, v40
    v_max_u32 v6, v9, v7
    v_min_u32 v7, v9, v7
    s_nop 1
    v_max_u32_dpp v6, v7, v6 row_half_mirror row_mask:0xf bank_mask:0xf
    v_bfe_u32 v15, v6, 5, 11
    v_sub_u32 v15, 2047, v15
    s_mov_b32 m0, 110592
    v_mul_u32_u24 v11, 1152, v15
    s_mov_b32 s44, 0
    v_add_u32 v13, v11, v12
    buffer_load_dwordx4 v13, s[24:27], s44 offen lds
    s_add_u32 m0, m0, 1024
    s_add_u32 s44, s44, 128
    buffer_load_dwordx4 v13, s[24:27], s44 offen lds
    s_add_u32 m0, m0, 1024
    s_add_u32 s44, s44, 128
    buffer_load_dwordx4 v13, s[24:27], s44 offen lds
    s_add_u32 m0, m0, 1024
    s_add_u32 s44, s44, 128
    buffer_load_dwordx4 v13, s[24:27], s44 offen lds
    s_add_u32 m0, m0, 1024
    s_add_u32 s44, s44, 128
    buffer_load_dwordx4 v13, s[24:27], s44 offen lds
    s_add_u32 m0, m0, 1024
    s_add_u32 s44, s44, 128
    buffer_load_dwordx4 v13, s[24:27], s44 offen lds
    s_add_u32 m0, m0, 1024
    s_add_u32 s44, s44, 128
    buffer_load_dwordx4 v13, s[24:27], s44 offen lds
    s_add_u32 m0, m0, 1024
    s_add_u32 s44, s44, 128
    buffer_load_dwordx4 v13, s[24:27], s44 offen lds
    s_add_u32 m0, m0, 1024
    s_add_u32 s44, s44, 128
    buffer_load_dwordx4 v13, s[24:27], s44 offen lds
    v_min_u32_dpp v9, v6, v6 quad_perm:[1,0,3,2] row_mask:0xf bank_mask:0xf
    v_sub_u32 v8, v64, v53
    v_sub_u32 v54, v65, v53
    v_max_u32 v10, v8, v54
    v_min_u32_dpp v9, v9, v9 quad_perm:[2,3,0,1] row_mask:0xf bank_mask:0xf
    v_sub_u32 v8, v66, v53
    v_sub_u32 v54, v67, v53
    v_max3_u32 v10, v10, v8, v54
    v_min_u32_dpp v9, v9, v9 row_half_mirror row_mask:0xf bank_mask:0xf
    v_sub_u32 v8, v68, v53
    v_sub_u32 v54, v69, v53
    v_max3_u32 v10, v10, v8, v54
    v_sub_u32 v8, v70, v53
    v_sub_u32 v54, v71, v53
    v_max3_u32 v10, v10, v8, v54
    v_sub_u32 v8, v72, v53
    v_sub_u32 v54, v73, v53
    v_max3_u32 v10, v10, v8, v54
    v_sub_u32 v8, v74, v53
    v_sub_u32 v54, v75, v53
    v_max3_u32 v10, v10, v8, v54
    v_sub_u32 v8, v76, v53
    v_sub_u32 v54, v77, v53
    v_max3_u32 v10, v10, v8, v54
    v_sub_u32 v8, v78, v53
    v_sub_u32 v54, v79, v53
    v_max3_u32 v10, v10, v8, v54
    v_sub_u32 v8, v80, v53
    v_sub_u32 v54, v81, v53
    v_max3_u32 v10, v10, v8, v54
    v_sub_u32 v8, v82, v53
    v_sub_u32 v54, v83, v53
    v_max3_u32 v10, v10, v8, v54
    v_sub_u32 v8, v84, v53
    v_sub_u32 v54, v85, v53
    v_max3_u32 v10, v10, v8, v54
    v_sub_u32 v8, v86, v53
    v_sub_u32 v54, v87, v53
    v_max3_u32 v10, v10, v8, v54
    v_sub_u32 v8, v88, v53
    v_sub_u32 v54, v89, v53
    v_max3_u32 v10, v10, v8, v54
    v_sub_u32 v8, v90, v53
    v_sub_u32 v54, v91, v53
    v_max3_u32 v10, v10, v8, v54
    v_sub_u32 v8, v92, v53
    v_sub_u32 v54, v93, v53
    v_max3_u32 v10, v10, v8, v54
    v_sub_u32 v8, v94, v53
    v_sub_u32 v54, v95, v53
    v_max3_u32 v10, v10, v8, v54
    v_add_u32 v10, v10, v53
    v_cmp_ge_u32 vcc, v10, v9
    s_cbranch_vccnz FALLBACK
SEL_DONE:
    v_mov_b32 v16, s20
    v_mov_b32 v17, v15
    s_mov_b64 exec, 0xff
    buffer_store_dwordx2 v[16:17], v52, s[28:31], s53 offen offset:640 sc1
    s_mov_b64 exec, -1
    s_barrier
    s_waitcnt vmcnt(10)
    v_cmp_ne_u32 vcc, s23, v37
    s_lshr_b32 s44, vcc_hi, 4
    v_mov_b32 v35, s44
    ds_write_b32 v33, v35 offset:4
    s_waitcnt vmcnt(1) lgkmcnt(0)
    s_barrier
    v_readlane_b32 s54, v6, s55
    s_nop 1
    v_mov_b32 v3, s54
    v_bfe_u32 v15, v3, 5, 11
    v_sub_u32 v15, 2047, v15
    v_mul_u32_u24 v11, 1152, v15
    v_add_u32 v5, v5, v11
    buffer_load_ushort v4, v5, s[24:27], 0 offen
    v_and_b32 v3, 0xffff0000, v3
    v_ashrrev_i32 v8, 31, v3
    v_not_b32 v8, v8
    v_or_b32 v8, 0x80000000, v8
    v_xor_b32 v3, v3, v8
    v_and_b32 v3, 0xffff0000, v3
    v_mul_f32 v3, 0xbfb8aa3b, v3
    v_exp_f32 v3, v3
    s_mov_b32 s48, 4194304
    v_add_f32 v3, 1.0, v3
    v_rcp_f32 v3, v3
    s_nop 0
    v_cvt_pk_bf16_f32 v3, v3, v3
    v_and_b32 v3, 0xffff0000, v3
    s_barrier
    s_barrier
G_POLL:
    buffer_load_dwordx4 v[16:19], v14, s[28:31], s60 offen sc1
    buffer_load_dwordx4 v[20:23], v14, s[28:31], s59 offen sc1
    s_sub_u32 s48, s48, 1
    s_waitcnt vmcnt(1)
    v_max3_u32 v8, v16, v17, v18
    v_max_u32 v8, v8, v19
    s_waitcnt vmcnt(0)
    v_max3_u32 v8, v8, v20, v21
    v_max3_u32 v8, v8, v22, v23
    v_cmp_eq_u32 vcc, -1, v8
    s_cbranch_vccz G_OK
    s_mov_b64 exec, vcc
    s_cbranch_scc0 G_POLL
G_OK:
    s_mov_b64 exec, -1
    v_add_f32 v16, v16, v20
    v_add_f32 v17, v17, v21
    v_add_f32 v18, v18, v22
    v_add_f32 v19, v19, v23
    s_nop 0
    v_permlane32_swap_b32 v16, v17
    v_permlane32_swap_b32 v18, v19
    v_add_f32 v16, v16, v17
    v_add_f32 v18, v18, v19
    v_lshlrev_b32 v4, 16, v4
    s_nop 0
    v_permlane16_swap_b32 v16, v18
    v_add_f32 v16, v16, v18
    s_nop 1
    v_add_f32_dpp v8, v16, v16 row_ror:8 row_mask:0xf bank_mask:0xf
    v_cvt_pk_bf16_f32 v8, v8, v8
    v_and_b32 v8, 0xffff0000, v8
    v_mul_f32 v8, v8, v3
    v_cvt_pk_bf16_f32 v8, v8, v8
    v_and_b32 v8, 0xffff0000, v8
    v_fma_f32 v8, v4, 0, v8
    v_add_f32 v8, v4, v8
    v_cvt_pk_bf16_f32 v8, v8, v8
    s_mov_b32 exec_lo, 0x00ff00ff
    s_mov_b32 exec_hi, 0x00ff00ff
    buffer_store_short v8, v5, s[40:43], 0 offen sc1
    s_barrier
    s_cmp_lg_u32 s2, 112
    s_cbranch_scc1 F_NOE
    s_mov_b64 exec, 1
    v_mov_b32 v8, s20
    v_mov_b32 v9, s21
    v_mov_b32 v10, 0
    buffer_store_dwordx2 v[8:9], v10, s[28:31], 0 offen sc1
F_NOE:
    s_endpgm
POLL_AGAIN:
    s_cbranch_scc1 POLL_OK
    buffer_load_dwordx4 v[64:67], v1, s[28:31], s46 offen offset:0 sc1
    buffer_load_dwordx4 v[68:71], v1, s[28:31], s46 offen offset:1024 sc1
    buffer_load_dwordx4 v[72:75], v1, s[28:31], s46 offen offset:2048 sc1
    buffer_load_dwordx4 v[76:79], v1, s[28:31], s46 offen offset:3072 sc1
    buffer_load_dwordx4 v[80:83], v1, s[28:31], s47 offen offset:0 sc1
    buffer_load_dwordx4 v[84:87], v1, s[28:31], s47 offen offset:1024 sc1
    buffer_load_dwordx4 v[88:91], v1, s[28:31], s47 offen offset:2048 sc1
    buffer_load_dwordx4 v[92:95], v1, s[28:31], s47 offen offset:3072 sc1
    s_branch POLL
FALLBACK:
    s_mov_b32 s44, 0
    s_mov_b32 s49, 0
    v_bfe_u32 v38, v0, 3, 1
    v_lshlrev_b32 v38, 2, v38
    v_xor_b32 v38, v38, v0
    v_and_b32 v38, 7, v38
FB_LOOP:
    v_subrev_u32 v8, s44, v64
    v_subrev_u32 v9, s44, v65
    v_max_u32 v7, v8, v9
    v_subrev_u32 v8, s44, v66
    v_subrev_u32 v9, s44, v67
    v_max3_u32 v7, v7, v8, v9
    v_subrev_u32 v8, s44, v68
    v_subrev_u32 v9, s44, v69
    v_max3_u32 v7, v7, v8, v9
    v_subrev_u32 v8, s44, v70
    v_subrev_u32 v9, s44, v71
    v_max3_u32 v7, v7, v8, v9
    v_subrev_u32 v8, s44, v72
    v_subrev_u32 v9, s44, v73
    v_max3_u32 v7, v7, v8, v9
    v_subrev_u32 v8, s44, v74
    v_subrev_u32 v9, s44, v75
    v_max3_u32 v7, v7, v8, v9
    v_subrev_u32 v8, s44, v76
    v_subrev_u32 v9, s44, v77
    v_max3_u32 v7, v7, v8, v9
    v_subrev_u32 v8, s44, v78
    v_subrev_u32 v9, s44, v79
    v_max3_u32 v7, v7, v8, v9
    v_subrev_u32 v8, s44, v80
    v_subrev_u32 v9, s44, v81
    v_max3_u32 v7, v7, v8, v9
    v_subrev_u32 v8, s44, v82
    v_subrev_u32 v9, s44, v83
    v_max3_u32 v7, v7, v8, v9
    v_subrev_u32 v8, s44, v84
    v_subrev_u32 v9, s44, v85
    v_max3_u32 v7, v7, v8, v9
    v_subrev_u32 v8, s44, v86
    v_subrev_u32 v9, s44, v87
    v_max3_u32 v7, v7, v8, v9
    v_subrev_u32 v8, s44, v88
    v_subrev_u32 v9, s44, v89
    v_max3_u32 v7, v7, v8, v9
    v_subrev_u32 v8, s44, v90
    v_subrev_u32 v9, s44, v91
    v_max3_u32 v7, v7, v8, v9
    v_subrev_u32 v8, s44, v92
    v_subrev_u32 v9, s44, v93
    v_max3_u32 v7, v7, v8, v9
    v_subrev_u32 v8, s44, v94
    v_subrev_u32 v9, s44, v95
    v_max3_u32 v7, v7, v8, v9
    s_nop 1
    v_max_u32_dpp v7, v7, v7 row_shr:1 row_mask:0xf bank_mask:0xf
    s_nop 1
    v_max_u32_dpp v7, v7, v7 row_shr:2 row_mask:0xf bank_mask:0xf
    s_nop 1
    v_max_u32_dpp v7, v7, v7 row_shr:4 row_mask:0xf bank_mask:0xf
    s_nop 1
    v_max_u32_dpp v7, v7, v7 row_shr:8 row_mask:0xf bank_mask:0xf
    s_nop 1
    v_max_u32_dpp v7, v7, v7 row_bcast:15 row_mask:0xa bank_mask:0xf
    s_nop 1
    v_max_u32_dpp v7, v7, v7 row_bcast:31 row_mask:0xc bank_mask:0xf
    s_nop 1
    v_readlane_b32 s45, v7, 63
    v_cmp_eq_u32 vcc, s49, v38
    s_nop 3
    s_add_u32 s44, s44, s45
    v_mov_b32 v8, s44
    v_cndmask_b32 v6, v6, v8, vcc
    s_add_u32 s49, s49, 1
    s_cmp_lt_u32 s49, 8
    s_cbranch_scc1 FB_LOOP
    v_bfe_u32 v15, v6, 5, 11
    v_sub_u32 v15, 2047, v15
    v_mul_u32_u24 v11, 1152, v15
    v_add_u32 v13, v11, v12
    s_mov_b32 m0, 110592
    s_mov_b32 s44, 0
FB_X:
    buffer_load_dwordx4 v13, s[24:27], s44 offen lds
    s_add_u32 m0, m0, 1024
    s_add_u32 s44, s44, 128
    s_cmp_lt_u32 s44, 1152
    s_cbranch_scc1 FB_X
    s_waitcnt vmcnt(0)
    s_branch SEL_DONE
CODE_END:
.section .rodata,"a"
.p2align 6
.amdhsa_kernel standalone__moe_arch_mod__prompt_kernel
  .amdhsa_next_free_vgpr 245
  .amdhsa_next_free_sgpr 100
  .amdhsa_accum_offset 248
  .amdhsa_group_segment_fixed_size 0
  .amdhsa_kernarg_size 64
  .amdhsa_user_sgpr_count 2
  .amdhsa_user_sgpr_kernarg_segment_ptr 1
  .amdhsa_system_sgpr_workgroup_id_x 1
  .amdhsa_float_denorm_mode_32 3
.end_amdhsa_kernel
```
